```python
import torch

def _softmax(x, axis=-1):
    return torch.softmax(x, dim=axis)
def _gelu(x):
    return torch.nn.functional.gelu(x, approximate="tanh")
def _silu(x):
    return torch.nn.functional.silu(x)
def _sigmoid(x):
    return torch.sigmoid(x)
def _layernorm(x, axis=-1, eps=1e-5):
    m = x.mean(dim=axis, keepdim=True)
    v = x.var(dim=axis, keepdim=True, unbiased=False)
    return (x - m) / torch.sqrt(v + eps)
def _scatter_add(tgt, idx, src, axis=0):
    return tgt.clone().index_add_(axis, idx, src)
def _segment_sum(src, seg, n):
    out = torch.zeros((n,) + src.shape[1:], dtype=src.dtype)
    return out.index_add_(0, seg, src)
def _pad(x, pw):
    flat = tuple(v for pair in reversed(pw) for v in pair)
    return torch.nn.functional.pad(x, flat)

kernel_name = 'recurrent_scan__sliding_block_cached__mixer_token_mlp__decode'

def setup_inputs():

    _w = (lambda a: (lambda t: t.to(torch.bfloat16) if t.is_floating_point() else t)(torch.as_tensor(a)))
    def _A_setup():
        B, Sq, D = 1, 1, 512
        Hq, Hkv, Sk, Dh = 32, 8, 65536, 128
        assert Hq % Hkv == 0, (Hq, Hkv)
        return {
            "x": _w((lambda *s: torch.randn(*s, dtype=torch.bfloat16) * 0.4)(B, Sq, D)),
            "k_cache": _w((lambda *s: torch.randn(*s, dtype=torch.bfloat16) * 1.6)(B, Hkv, Sk, Dh)),
            "v_cache": _w((lambda *s: torch.randn(*s, dtype=torch.bfloat16) * 1.6)(B, Hkv, Sk, Dh)),
            "wq": _w((lambda *s: torch.randn(*s, dtype=torch.bfloat16) * 1.6)(D, Hq * Dh) * (D ** -0.5)),
            "wo": _w((lambda *s: torch.randn(*s, dtype=torch.bfloat16) * 1.6)(Hq * Dh, D) * ((Hq * Dh) ** -0.5)),
        }
    _A_in = _A_setup()

    def _B_setup():
        B, S, D, F = 1, 1, 512, 1792
        return {
            "x": _w((lambda *s: torch.randn(*s, dtype=torch.bfloat16) * 0.4)(B, S, D)),
            "w1": _w((lambda *s: torch.randn(*s, dtype=torch.bfloat16) * 1.6)(S, F) * (S ** -0.5)),
            "b1": _w((lambda *s: torch.randn(*s, dtype=torch.bfloat16) * 1.6)(F) * 0.02),
            "w2": _w((lambda *s: torch.randn(*s, dtype=torch.bfloat16) * 1.6)(F, S) * (F ** -0.5)),
            "b2": _w((lambda *s: torch.randn(*s, dtype=torch.bfloat16) * 1.6)(S) * 0.02),
        }
    _B_in = _B_setup()

    return {
        "A_x": _A_in["x"],
        "A_k_cache": _A_in["k_cache"],
        "A_v_cache": _A_in["v_cache"],
        "A_wq": _A_in["wq"],
        "A_wo": _A_in["wo"],
        "B_x": _B_in["x"],
        "B_w1": _B_in["w1"],
        "B_b1": _B_in["b1"],
        "B_w2": _B_in["w2"],
        "B_b2": _B_in["b2"],
    }

def reference(A_x, A_k_cache, A_v_cache, A_wq, A_wo, B_x, B_w1, B_b1, B_w2, B_b2):
    def _A_ref(x, k_cache, v_cache, wq, wo):
        B, Sq, D = x.shape
        Hq, Dh = 32, 128
        Hkv, Sk = k_cache.shape[1], k_cache.shape[2]
        W = min(4096, max(256, Sk // 4))
        rep = Hq // Hkv
        q = (lambda x, *d: x.permute(*d))((x @ wq).reshape(B, Sq, Hq, Dh), 0, 2, 1, 3)
        k = (lambda x, n, axis: torch.repeat_interleave(x, n, dim=axis))(k_cache[:, :, Sk - W:, :], rep, axis=1)
        v = (lambda x, n, axis: torch.repeat_interleave(x, n, dim=axis))(v_cache[:, :, Sk - W:, :], rep, axis=1)
        scores = torch.einsum("bhqd,bhkd->bhqk", q, k) * (Dh ** -0.5)
        p = _softmax(scores, axis=-1)
        o = torch.einsum("bhqk,bhkd->bhqd", p, v)
        return (lambda x, *d: x.permute(*d))(o, 0, 2, 1, 3).reshape(B, Sq, Hq * Dh) @ wo

    def _B_ref(x, w1, b1, w2, b2):
        B, S, D = x.shape
        h = _layernorm(x, axis=-1)
        u = torch.einsum("bsd,sf->bdf", h, w1) + b1
        u = _gelu(u)
        y = torch.einsum("bdf,fs->bds", u, w2) + b2
        return (lambda x, *d: x.permute(*d))(y, 0, 2, 1)

    x = A_x
    xn = _layernorm(x, axis=-1)
    s = _A_ref(xn, A_k_cache, A_v_cache, A_wq, A_wo)
    g = _silu(_B_ref(xn, B_w1, B_b1, B_w2, B_b2))
    return x + s * g
```

```asm
; @launch grid=(256,1,1) block=(576,1,1) lds=106496
.amdgcn_target "amdgcn-amd-amdhsa--gfx950"
.text
.globl recurrent_scan__sliding_block_cached__mixer_token_mlp__decode_kernel
.p2align 8
.type recurrent_scan__sliding_block_cached__mixer_token_mlp__decode_kernel,@function
recurrent_scan__sliding_block_cached__mixer_token_mlp__decode_kernel:
    s_lshr_b32 s3, s2, 8
    s_cbranch_scc1 L_exit
    s_load_dwordx16 s[8:23], s[0:1], 0
    s_load_dwordx8 s[24:31], s[0:1], 64
    s_load_dwordx2 s[32:33], s[0:1], 96
    v_lshrrev_b32 v1, 6, v0
    v_and_b32 v0, 63, v0
    v_mov_b32 v2, 0
    v_readfirstlane_b32 s3, v1
    s_and_b32 s4, s2, 7
    s_lshr_b32 s5, s2, 3
    s_cmp_eq_u32 s3, 8
    s_cbranch_scc1 L_ld0
    s_mov_b64 exec, 0
    s_cmp_eq_u32 s3, 1
    s_cbranch_scc1 L_pad2
    s_cmp_eq_u32 s3, 2
    s_cbranch_scc1 L_pad3
    s_cmp_eq_u32 s3, 3
    s_cbranch_scc1 L_pad4
L_touch_ret:
    s_mov_b64 exec, -1
    s_branch L_pre
L_ld0:
    v_lshrrev_b32 v1, 3, v0
    v_lshrrev_b32 v4, 4, v0
    v_and_b32 v5, 7, v0
    v_lshlrev_b32 v6, 1, v4
    v_xor_b32 v5, v5, v6
    v_lshlrev_b32 v5, 4, v5
    v_lshl_add_u32 v5, v1, 13, v5
    v_lshlrev_b32 v7, 4, v0
    s_lshr_b32 s34, s5, 3
    s_and_b32 s35, s5, 7
    s_lshl_b32 s34, s34, 20
    s_lshl_b32 s35, s35, 7
    s_add_u32 s34, s34, s35
    s_lshl_b32 s35, s4, 10
    s_add_u32 s34, s34, s35
    s_movk_i32 m0, 4096
    s_lshl_b32 s54, 1, 16
    s_waitcnt lgkmcnt(0)
    global_load_lds_dwordx4 v7, s[8:9]
    s_movk_i32 m0, 5120
    v_add_u32 v5, s34, v5
    global_load_lds_dword v2, s[32:33] sc1
    s_movk_i32 m0, 8192
    v_add_u32 v8, s54, v5
L_ldq:
    global_load_lds_dwordx4 v5, s[14:15] nt
    s_addk_i32 m0, 0x400
    v_add_u32 v5, s54, v8
    global_load_lds_dwordx4 v8, s[14:15] nt
    s_addk_i32 m0, 0x400
    v_add_u32 v8, s54, v5
    s_cmp_lt_u32 m0, 24576
    s_cbranch_scc1 L_ldq
    s_branch L_loader
.p2align 10
L_loader:
    s_setprio 3
    s_mov_b32 s6, 0x400000
    s_movk_i32 s53, 0x400
    v_mov_b32 v20, 1
    s_barrier
    s_waitcnt vmcnt(16)
    s_mov_b64 exec, 1
    ds_write_b32 v2, v20 offset:48
    s_mov_b64 exec, -1
    s_mov_b32 s40, s10
    s_mov_b32 s41, s11
    s_mov_b32 s42, 0x8000000
    s_mov_b32 s43, 0x20000
    s_lshl_b32 s34, s4, 24
    s_lshl_b32 s35, s5, 15
    s_add_u32 s34, s34, s35
    s_add_u32 s34, s34, 0xf00000
    v_and_b32 v6, 15, v0
    v_xor_b32 v7, v6, v4
    v_lshlrev_b32 v7, 4, v7
    v_lshl_add_u32 v7, v4, 8, v7
    v_add_u32 v8, s34, v7
    v_xor_b32 v9, 64, v8
    v_xor_b32 v10, 0x80, v8
    v_xor_b32 v11, 0xc0, v8
    s_mov_b32 s55, s5
    s_add_u32 s56, s5, 8
    s_add_u32 s57, s5, 4
    s_add_u32 s59, s5, 2
    s_waitcnt vmcnt(12)
L_ldk:
    s_and_b32 s52, s55, 7
    s_lshl_b32 s52, s52, 12
    s_add_u32 m0, s52, 24576
    s_waitcnt vmcnt(16)
    s_cmp_eq_u32 s55, s57
    s_cbranch_scc0 L_ldk1
    s_mov_b64 exec, 1
    ds_write_b32 v2, v20 offset:0
    s_mov_b64 exec, -1
L_ldk1:
    buffer_load_dwordx4 v8, s[40:43], s52 offen nt lds
    buffer_load_dwordx4 v9, s[40:43], s52 offen offset:1024 nt lds
    buffer_load_dwordx4 v10, s[40:43], s52 offen offset:2048 nt lds
    buffer_load_dwordx4 v11, s[40:43], s52 offen offset:3072 nt lds
    s_add_u32 s55, s55, 1
    s_cmp_lt_u32 s55, s56
    s_cbranch_scc1 L_ldk
    s_branch L_loader_b
L_pre:
    s_mov_b32 s6, 0x400000
    v_lshlrev_b32 v3, 4, v0
    s_waitcnt lgkmcnt(0)
    s_mov_b32 s92, s32
    s_mov_b32 s93, s33
    s_mov_b32 s94, 0x400000
    s_mov_b32 s95, 0x20000
    s_cmp_ge_u32 s3, 4
    s_cbranch_scc1 L_pre_aux
    s_mov_b32 s36, 1
    s_mov_b32 s7, 0
    s_branch L_ln
L_pre_aux:
    s_sub_u32 s35, s3, 4
    s_lshl_b32 s35, s35, 10
    v_lshlrev_b32 v3, 4, v0
    v_add_u32 v5, s35, v3
    v_mov_b32 v28, 0
    v_mov_b32 v29, 0
    v_mov_b32 v30, 0
    v_mov_b32 v31, 0
    v_mov_b32 v32, 0
    v_mov_b32 v33, 0
    v_mov_b32 v34, 0
    v_mov_b32 v35, 0
    v_mov_b32 v36, 0
    v_mov_b32 v37, 0
    v_mov_b32 v38, 0
    v_mov_b32 v39, 0
    v_cmp_gt_u32 vcc, 0xe00, v5
    s_and_saveexec_b64 s[34:35], vcc
    global_load_dwordx4 v[28:31], v5, s[20:21]
    global_load_dwordx4 v[32:35], v5, s[22:23]
    global_load_dwordx4 v[36:39], v5, s[24:25]
    s_mov_b64 exec, -1
    s_mov_b32 s36, 2
    s_mov_b32 s7, 1
    s_branch L_ln
L_loader_b:
    s_mov_b32 s44, s12
    s_mov_b32 s45, s13
    s_mov_b32 s46, 0x8000000
    s_mov_b32 s47, 0x20000
    v_lshlrev_b32 v7, 1, v4
    v_xor_b32 v7, v6, v7
    v_lshlrev_b32 v7, 4, v7
    v_lshl_add_u32 v7, v4, 8, v7
    v_add_u32 v8, s34, v7
    v_xor_b32 v9, 0x80, v8
    s_mov_b32 s55, s5
    s_add_u32 s58, s5, 0
    s_add_u32 s57, s5, 4
L_ldv:
    s_and_b32 s52, s55, 7
    s_lshl_b32 s52, s52, 12
    s_add_u32 m0, s52, 57344
    s_waitcnt vmcnt(16)
    s_cmp_gt_u32 s55, s59
    s_cbranch_scc1 L_ldv0
    s_waitcnt vmcnt(16)
L_ldv0:
    s_cmp_eq_u32 s55, s57
    s_cbranch_scc0 L_ldv1
    s_mov_b64 exec, 1
    ds_write_b32 v2, v20 offset:4
    s_mov_b64 exec, -1
L_ldv1:
    s_cmp_eq_u32 s55, s59
    s_cbranch_scc0 L_ldv2
    s_mov_b64 exec, 1
    ds_write_b32 v2, v20 offset:40
    s_mov_b64 exec, -1
L_ldv2:
    buffer_load_dwordx4 v8, s[44:47], s52 offen nt lds
    buffer_load_dwordx4 v9, s[44:47], s52 offen offset:1024 nt lds
    buffer_load_dwordx4 v8, s[44:47], s52 offen offset:2048 nt lds
    buffer_load_dwordx4 v9, s[44:47], s52 offen offset:3072 nt lds
    s_add_u32 s55, s55, 1
    s_cmp_lt_u32 s55, s56
    s_cbranch_scc1 L_ldv
    s_mov_b32 s48, s16
    s_mov_b32 s49, s17
    s_mov_b32 s50, 0x400000
    s_mov_b32 s51, 0x20000
    v_lshrrev_b32 v1, 3, v0
    v_and_b32 v5, 7, v0
    v_lshlrev_b32 v6, 1, v4
    v_xor_b32 v5, v5, v6
    v_lshlrev_b32 v5, 4, v5
    v_lshl_add_u32 v5, v1, 10, v5
    s_lshr_b32 s34, s5, 3
    s_and_b32 s35, s5, 7
    s_lshl_b32 s34, s34, 17
    s_lshl_b32 s35, s35, 7
    s_add_u32 s34, s34, s35
    s_lshl_b32 s35, s4, 19
    s_add_u32 s34, s34, s35
    v_add_u32 v5, s34, v5
    s_mov_b32 s52, 0
    s_movk_i32 s54, 0x2000
    s_mov_b32 m0, 90112
L_ldo:
    s_waitcnt vmcnt(16)
    buffer_load_dwordx4 v5, s[48:51], s52 offen nt lds
    s_add_u32 m0, m0, s53
    s_add_u32 s52, s52, s54
    buffer_load_dwordx4 v5, s[48:51], s52 offen nt lds
    s_add_u32 m0, m0, s53
    s_add_u32 s52, s52, s54
    buffer_load_dwordx4 v5, s[48:51], s52 offen nt lds
    s_add_u32 m0, m0, s53
    s_add_u32 s52, s52, s54
    buffer_load_dwordx4 v5, s[48:51], s52 offen nt lds
    s_add_u32 m0, m0, s53
    s_add_u32 s52, s52, s54
    s_cmp_lt_u32 s52, 0x20000
    s_cbranch_scc1 L_ldo
    s_waitcnt vmcnt(16)
    s_mov_b64 exec, 1
    ds_write_b32 v2, v20 offset:8
    s_waitcnt vmcnt(0)
    ds_write_b32 v2, v20 offset:12
    s_mov_b64 exec, -1
    s_endpgm
L_ln:
    v_lshlrev_b32 v4, 2, v0
    ds_write_b32 v4, v2
    s_waitcnt lgkmcnt(0)
    s_barrier
    s_mov_b64 exec, 0
    s_cmp_eq_u32 s3, 4
    s_cbranch_scc1 L_pad5
    s_cmp_eq_u32 s3, 5
    s_cbranch_scc1 L_pad6
    s_cmp_eq_u32 s3, 6
    s_cbranch_scc1 L_pad7
    s_cmp_eq_u32 s3, 7
    s_cbranch_scc1 L_pad8
L_touch_ret2:
    s_cmp_eq_u32 s3, 5
    s_cbranch_scc1 L_pad9
L_touch_ret3:
    s_mov_b64 exec, -1
    s_cmp_eq_u32 s7, 1
    s_cbranch_scc1 L_ln_x
    v_lshrrev_b32 v1, 4, v0
    v_and_b32 v3, 15, v0
    s_lshr_b32 s34, s5, 3
    s_and_b32 s35, s5, 7
    v_lshlrev_b32 v126, 3, v1
    s_mov_b32 s43, 0xffffff00
    s_mov_b32 s44, 0x0c0c0400
    s_mov_b32 s45, 0x04000c0c
    v_lshrrev_b32 v24, 2, v3
    v_and_b32 v25, 3, v3
    v_lshl_add_u32 v26, v1, 2, v24
    v_lshrrev_b32 v27, 1, v25
    v_and_b32 v28, 1, v25
    v_lshrrev_b32 v29, 1, v26
    v_and_b32 v29, 3, v29
    v_lshlrev_b32 v29, 1, v29
    s_lshl_b32 s36, s3, 1
    v_add_u32 v30, s36, v27
    v_xor_b32 v30, v30, v29
    v_lshlrev_b32 v30, 4, v30
    v_lshl_add_u32 v30, v26, 7, v30
    v_lshl_add_u32 v30, v28, 3, v30
    v_add_u32 v104, 8192, v30
L_pad2:
    s_cbranch_execz L_touch_ret
    v_add_u32 v105, 90112, v30
    s_lshl_b32 s36, s4, 13
    s_add_u32 s36, s36, 0x00001000
    s_lshl_b32 s37, s34, 11
    s_lshl_b32 s42, s35, 8
    s_add_u32 s37, s37, s42
    s_lshl_b32 s42, s3, 6
    s_add_u32 s37, s37, s42
    s_add_u32 s37, s37, s36
    v_lshl_add_u32 v106, v1, 4, s37
    v_lshrrev_b32 v29, 5, v0
    v_and_b32 v30, 31, v0
    v_lshlrev_b32 v31, 11, v29
    v_lshl_add_u32 v31, v30, 4, v31
    s_lshl_b32 s42, s3, 9
    s_add_u32 s42, s42, s36
    v_add_u32 v107, s42, v31
    v_add_u32 v108, 0x1000, v107
    s_mul_i32 s42, s3, 272
    v_lshl_add_u32 v31, v30, 3, s42
    v_lshl_add_u32 v109, v29, 2, v31
    v_mul_u32_u24 v31, 272, v25
    v_lshl_add_u32 v110, v1, 4, v31
    v_xor_b32 v31, v1, v3
    v_lshlrev_b32 v31, 4, v31
    v_lshl_add_u32 v31, v3, 8, v31
    s_lshl_b32 s42, s3, 13
    s_add_u32 s42, s42, 24576
    v_add_u32 v111, s42, v31
    v_xor_b32 v112, 64, v111
    v_xor_b32 v113, 0x80, v111
    v_xor_b32 v114, 0xc0, v111
    v_lshlrev_b32 v116, 4, v25
    s_lshl_b32 s42, s3, 2
    v_add_u32 v115, s42, v116
    v_lshlrev_b32 v118, 4, v0
    s_lshl_b32 s42, s3, 10
    v_add_u32 v117, s42, v118
    v_and_b32 v31, 7, v26
    v_lshlrev_b32 v31, 1, v31
    s_lshl_b32 s42, s3, 2
    v_xor_b32 v31, s42, v31
    v_or_b32 v31, v31, v27
    v_lshlrev_b32 v31, 4, v31
    v_lshl_add_u32 v31, v26, 8, v31
    v_lshl_add_u32 v31, v28, 3, v31
    v_add_u32 v119, 57344, v31
    v_xor_b32 v120, 32, v119
    s_lshl_b32 s42, s4, 16
    s_lshl_b32 s46, s3, 7
    s_add_u32 s42, s42, s46
    s_add_u32 s42, s42, 0x00040000
    s_lshl_b32 s46, s5, 9
    s_add_u32 s46, s46, s42
    v_lshlrev_b32 v31, 14, v25
    v_lshl_add_u32 v31, v1, 4, v31
    v_and_b32 v32, 4, v3
    v_lshl_add_u32 v31, v32, 4, v31
    v_add_u32 v121, s46, v31
    s_lshl_b32 s46, s34, 14
    s_add_u32 s46, s46, s42
    v_lshrrev_b32 v31, 3, v0
    v_lshlrev_b32 v32, 9, v31
    v_and_b32 v33, 7, v0
    v_lshl_add_u32 v32, v33, 4, v32
    v_add_u32 v122, s46, v32
    v_lshlrev_b32 v123, 2, v31
    s_lshl_b32 s42, s35, 13
    s_lshl_b32 s46, s3, 11
    s_add_u32 s42, s42, s46
    s_lshl_b32 s46, s4, 8
    s_add_u32 s42, s42, s46
    s_lshl_b32 s46, s34, 6
    s_add_u32 s42, s42, s46
    s_add_u32 s42, s42, 0x00018000
    v_lshl_add_u32 v124, v1, 4, s42
    v_cmp_lt_u32 s[50:51], 3, v3
    s_movk_i32 s60, 0x1000
    s_movk_i32 s61, 0x2000
    s_movk_i32 s62, 0x3000
    v_lshlrev_b32 v31, 3, v33
    v_lshl_add_u32 v31, v1, 1, v31
    s_lshl_b32 s42, s3, 6
    v_add_u32 v125, s42, v31
    s_mov_b64 exec, 1
    buffer_load_dword v127, v106, s[92:95], 0 offen sc1
    s_mov_b64 exec, -1
    s_mov_b32 s36, 1
L_ln_x:
    s_mov_b32 s37, 2048
    v_lshlrev_b32 v18, 4, v0
L_wd1:
    ds_read_b32 v5, v2 offset:48
    ds_read_b128 v[20:23], v18 offset:4096
    ds_read_b32 v24, v2 offset:5120
    s_sub_u32 s6, s6, 1
    s_cbranch_scc1 L_exit
    s_waitcnt lgkmcnt(0)
    v_readfirstlane_b32 s58, v5
    s_cmp_ge_u32 s58, 1
    s_cbranch_scc0 L_wd1
L_ln_loop:
    v_lshlrev_b32 v8, 16, v20
    v_and_b32 v9, 0xffff0000, v20
    v_lshlrev_b32 v10, 16, v21
    v_and_b32 v11, 0xffff0000, v21
    v_lshlrev_b32 v12, 16, v22
    v_and_b32 v13, 0xffff0000, v22
    v_lshlrev_b32 v14, 16, v23
    v_and_b32 v15, 0xffff0000, v23
    v_readfirstlane_b32 s42, v8
    s_nop 1
    v_subrev_f32 v40, s42, v8
    v_subrev_f32 v41, s42, v9
    v_subrev_f32 v42, s42, v10
    v_subrev_f32 v43, s42, v11
    v_subrev_f32 v44, s42, v12
    v_subrev_f32 v45, s42, v13
    v_subrev_f32 v46, s42, v14
    v_subrev_f32 v47, s42, v15
    v_add_f32 v4, v40, v41
    v_mul_f32 v5, v40, v40
    v_add_f32 v6, v42, v43
    v_fmac_f32 v5, v41, v41
    v_add_f32 v7, v44, v45
    v_mul_f32 v16, v42, v42
    v_add_f32 v17, v46, v47
    v_fmac_f32 v16, v43, v43
    v_add_f32 v4, v4, v6
    v_fmac_f32 v5, v44, v44
    v_add_f32 v7, v7, v17
    v_fmac_f32 v16, v45, v45
    v_fmac_f32 v5, v46, v46
    v_fmac_f32 v16, v47, v47
    v_add_f32 v4, v4, v7
    v_add_f32 v5, v5, v16
    s_nop 1
    v_add_f32_dpp v4, v4, v4 quad_perm:[1,0,3,2] row_mask:0xf bank_mask:0xf
    v_add_f32_dpp v5, v5, v5 quad_perm:[1,0,3,2] row_mask:0xf bank_mask:0xf
    s_nop 1
    v_add_f32_dpp v4, v4, v4 quad_perm:[2,3,0,1] row_mask:0xf bank_mask:0xf
    v_add_f32_dpp v5, v5, v5 quad_perm:[2,3,0,1] row_mask:0xf bank_mask:0xf
    s_nop 1
    v_add_f32_dpp v4, v4, v4 row_half_mirror row_mask:0xf bank_mask:0xf
    v_add_f32_dpp v5, v5, v5 row_half_mirror row_mask:0xf bank_mask:0xf
    s_nop 1
    v_add_f32_dpp v4, v4, v4 row_mirror row_mask:0xf bank_mask:0xf
    v_add_f32_dpp v5, v5, v5 row_mirror row_mask:0xf bank_mask:0xf
    v_mov_b32 v6, v4
    v_mov_b32 v7, v5
    s_nop 1
    v_permlane16_swap_b32 v4, v6
    v_permlane16_swap_b32 v5, v7
    v_add_f32 v4, v4, v6
    v_add_f32 v5, v5, v7
    v_mov_b32 v6, v4
    v_mov_b32 v7, v5
    s_nop 1
    v_permlane32_swap_b32 v4, v6
    v_permlane32_swap_b32 v5, v7
    v_add_f32 v4, v4, v6
    v_add_f32 v5, v5, v7
    v_mul_f32 v4, 0x3b000000, v4
    v_mul_f32 v5, 0x3b000000, v5
    v_fma_f32 v5, -v4, v4, v5
    v_add_f32 v4, s42, v4
    v_max_f32 v5, 0, v5
    v_cvt_pk_bf16_f32 v5, v5, v5
    v_cvt_pk_bf16_f32 v4, v4, v4
    v_and_b32 v5, 0xffff0000, v5
    v_and_b32 v4, 0xffff0000, v4
    v_add_f32 v5, 0x3727c5ac, v5
    v_pk_add_f32 v[40:41], v[8:9], v[4:5] op_sel_hi:[1,0] neg_lo:[0,1] neg_hi:[0,1]
    v_cvt_pk_bf16_f32 v5, v5, v5
    v_pk_add_f32 v[42:43], v[10:11], v[4:5] op_sel_hi:[1,0] neg_lo:[0,1] neg_hi:[0,1]
    v_and_b32 v5, 0xffff0000, v5
    v_pk_add_f32 v[44:45], v[12:13], v[4:5] op_sel_hi:[1,0] neg_lo:[0,1] neg_hi:[0,1]
    v_sqrt_f32 v16, v5
    v_pk_add_f32 v[46:47], v[14:15], v[4:5] op_sel_hi:[1,0] neg_lo:[0,1] neg_hi:[0,1]
    v_cvt_pk_bf16_f32 v8, v40, v41
    v_cvt_pk_bf16_f32 v16, v16, v16
    v_cvt_pk_bf16_f32 v9, v42, v43
    v_and_b32 v16, 0xffff0000, v16
    v_cvt_pk_bf16_f32 v10, v44, v45
    v_rcp_f32 v16, v16
    v_cvt_pk_bf16_f32 v11, v46, v47
    v_lshlrev_b32 v40, 16, v8
    v_and_b32 v41, 0xffff0000, v8
    v_lshlrev_b32 v42, 16, v9
    v_and_b32 v43, 0xffff0000, v9
    v_lshlrev_b32 v44, 16, v10
    v_and_b32 v45, 0xffff0000, v10
    v_lshlrev_b32 v46, 16, v11
L_pad3:
    s_cbranch_execz L_touch_ret
    v_and_b32 v47, 0xffff0000, v11
    v_pk_mul_f32 v[40:41], v[40:41], v[16:17] op_sel_hi:[1,0]
    v_pk_mul_f32 v[42:43], v[42:43], v[16:17] op_sel_hi:[1,0]
    v_pk_mul_f32 v[44:45], v[44:45], v[16:17] op_sel_hi:[1,0]
    v_pk_mul_f32 v[46:47], v[46:47], v[16:17] op_sel_hi:[1,0]
    v_cvt_pk_bf16_f32 v20, v40, v41
    v_cvt_pk_bf16_f32 v21, v42, v43
    v_cvt_pk_bf16_f32 v22, v44, v45
    v_cvt_pk_bf16_f32 v23, v46, v47
    v_lshl_add_u32 v6, v0, 4, s37
    ds_write_b128 v6, v[20:23]
    s_add_u32 s37, s37, 1024
    s_sub_u32 s36, s36, 1
    s_cmp_lg_u32 s36, 0
    s_cbranch_scc1 L_ln_loop
    v_readfirstlane_b32 s38, v24
    s_add_u32 s38, s38, 1
    s_mul_i32 s39, s38, 0x9e3779b1
    s_and_b32 s40, s39, 0xff
    s_mul_i32 s41, s40, 0x01010101
    s_cmp_eq_u32 s7, 1
    s_cbranch_scc1 L_aux
L_att:
    s_setprio 2
    s_lshl_b32 s36, s34, 8
    s_add_u32 s36, s36, 2048
    v_add_u32 v5, s36, v126
    v_mov_b32 v4, 1
    v_mov_b32 v6, s40
    ds_read2_b64 v[8:11], v5 offset0:0 offset1:4
    ds_read2_b64 v[12:15], v5 offset0:8 offset1:12
    ds_read2_b64 v[16:19], v5 offset0:16 offset1:20
    ds_read2_b64 v[20:23], v5 offset0:24 offset1:28
L_wf3:
    ds_read_b32 v32, v2 offset:0
    s_sub_u32 s6, s6, 1
    s_cbranch_scc1 L_exit
    s_waitcnt lgkmcnt(0)
    v_readfirstlane_b32 s58, v32
    s_cmp_ge_u32 s58, 1
    s_cbranch_scc0 L_wf3
    ds_read_b64_tr_b16 v[36:37], v104 offset:0
    ds_read_b64_tr_b16 v[38:39], v104 offset:2048
    ds_read_b64_tr_b16 v[40:41], v104 offset:4096
    ds_read_b64_tr_b16 v[42:43], v104 offset:6144
    ds_read_b64_tr_b16 v[44:45], v104 offset:8192
    ds_read_b64_tr_b16 v[46:47], v104 offset:10240
    ds_read_b64_tr_b16 v[48:49], v104 offset:12288
    ds_read_b64_tr_b16 v[50:51], v104 offset:14336
    s_waitcnt lgkmcnt(6)
    v_mfma_f32_16x16x32_bf16 v[32:35], v[36:39], v[8:11], 0
    s_waitcnt lgkmcnt(4)
    v_mfma_f32_16x16x32_bf16 v[32:35], v[40:43], v[12:15], v[32:35]
    s_waitcnt lgkmcnt(2)
    v_mfma_f32_16x16x32_bf16 v[32:35], v[44:47], v[16:19], v[32:35]
    s_waitcnt lgkmcnt(0)
    v_mfma_f32_16x16x32_bf16 v[32:35], v[48:51], v[20:23], v[32:35]
    s_mov_b32 exec_lo, 0x00010001
    s_mov_b32 exec_hi, 0x00010001
    s_nop 5
    v_and_or_b32 v96, v32, s43, v6
    v_and_or_b32 v97, v33, s43, v6
    v_and_or_b32 v98, v34, s43, v6
    v_and_or_b32 v99, v35, s43, v6
    buffer_store_dwordx4 v[96:99], v106, s[92:95], 0 offen
    s_mov_b64 exec, -1
L_wf4:
    ds_read_b32 v36, v2 offset:40
    s_sub_u32 s6, s6, 1
    s_cbranch_scc1 L_exit
    s_waitcnt lgkmcnt(0)
    v_readfirstlane_b32 s58, v36
    s_cmp_ge_u32 s58, 1
    s_cbranch_scc0 L_wf4
    s_mov_b32 s46, 0
    buffer_load_dwordx4 v[36:39], v107, s[92:95], 0 offen sc1
    buffer_load_dwordx4 v[40:43], v108, s[92:95], 0 offen sc1
L_wf9:
    ds_read_b32 v44, v2 offset:4
    s_sub_u32 s6, s6, 1
    s_cbranch_scc1 L_exit
    s_waitcnt lgkmcnt(0)
    v_readfirstlane_b32 s58, v44
    s_cmp_ge_u32 s58, 1
    s_cbranch_scc0 L_wf9
    ds_read_b128 v[64:67], v111 offset:0
    ds_read_b128 v[68:71], v112 offset:0
    ds_read_b128 v[72:75], v113 offset:0
    ds_read_b128 v[76:79], v114 offset:0
    ds_read_b128 v[80:83], v111 offset:4096
    ds_read_b128 v[84:87], v112 offset:4096
    ds_read_b128 v[88:91], v113 offset:4096
    ds_read_b128 v[92:95], v114 offset:4096
    s_add_u32 s46, s46, 1
    s_waitcnt vmcnt(0)
    v_perm_b32 v44, v37, v36, s44
    v_perm_b32 v45, v39, v38, s45
    v_perm_b32 v46, v41, v40, s44
    v_perm_b32 v47, v43, v42, s45
    v_or_b32 v44, v44, v45
    v_or_b32 v46, v46, v47
    v_cmp_eq_u32 vcc, s41, v44
    v_cmp_eq_u32 s[48:49], s41, v46
    s_and_b64 vcc, vcc, s[48:49]
    s_cmp_eq_u64 vcc, -1
    s_cbranch_scc1 L_qok6
L_qpoll5:
    buffer_load_dwordx4 v[36:39], v107, s[92:95], 0 offen sc1
    buffer_load_dwordx4 v[40:43], v108, s[92:95], 0 offen sc1
    s_cmp_eq_u32 s46, 4
    s_cbranch_scc0 L_qnors7
    s_mov_b32 exec_lo, 0x00010001
    s_mov_b32 exec_hi, 0x00010001
    buffer_store_dwordx4 v[96:99], v106, s[92:95], 0 offen sc1
    s_mov_b64 exec, -1
L_qnors7:
    s_add_u32 s46, s46, 1
    s_waitcnt vmcnt(0)
    v_perm_b32 v44, v37, v36, s44
    v_perm_b32 v45, v39, v38, s45
    v_perm_b32 v46, v41, v40, s44
    v_perm_b32 v47, v43, v42, s45
    v_or_b32 v44, v44, v45
    v_or_b32 v46, v46, v47
    v_cmp_eq_u32 vcc, s41, v44
    v_cmp_eq_u32 s[48:49], s41, v46
    s_and_b64 vcc, vcc, s[48:49]
    s_cmp_eq_u64 vcc, -1
    s_cbranch_scc1 L_qok6
    s_cmp_lt_u32 s46, 32768
    s_cbranch_scc1 L_qpoll5
L_qok6:
    v_and_b32 v36, s43, v36
    v_and_b32 v37, s43, v37
    v_and_b32 v38, s43, v38
    v_and_b32 v39, s43, v39
    v_and_b32 v40, s43, v40
    v_and_b32 v41, s43, v41
    v_and_b32 v42, s43, v42
    v_and_b32 v43, s43, v43
    v_add_f32 v36, v36, v40
    v_add_f32 v37, v37, v41
    v_add_f32 v38, v38, v42
    v_add_f32 v39, v39, v43
    s_nop 0
    v_permlane32_swap_b32 v36, v38
    v_permlane32_swap_b32 v37, v39
    v_add_f32 v36, v36, v38
    v_add_f32 v37, v37, v39
    v_cvt_pk_bf16_f32 v36, v36, v37
    ds_write_b32 v109, v36 offset:256
    s_mov_b64 exec, 1
    ds_add_u32 v2, v4 offset:16
    s_mov_b64 exec, -1
    s_mov_b32 s63, 0
L_wd10:
    ds_read_b32 v40, v2 offset:16
    ds_read_b128 v[8:11], v110 offset:256
    ds_read_b128 v[12:15], v110 offset:320
    ds_read_b128 v[16:19], v110 offset:384
    ds_read_b128 v[20:23], v110 offset:448
    s_add_u32 s63, s63, 1
    s_cmp_eq_u32 s63, 70
    s_cbranch_scc0 L_wdN11
    s_mov_b32 exec_lo, 0x00010001
    s_mov_b32 exec_hi, 0x00010001
    buffer_store_dwordx4 v[96:99], v106, s[92:95], 0 offen sc1
    s_mov_b64 exec, -1
L_wdN11:
    s_sub_u32 s6, s6, 1
    s_cbranch_scc1 L_exit
    s_waitcnt lgkmcnt(0)
    v_readfirstlane_b32 s58, v40
    s_cmp_ge_u32 s58, 4
    s_cbranch_scc0 L_wd10
    v_mfma_f32_16x16x32_bf16 v[40:43], v[64:67], v[8:11], 0
    v_mfma_f32_16x16x32_bf16 v[44:47], v[80:83], v[8:11], 0
    v_mfma_f32_16x16x32_bf16 v[40:43], v[68:71], v[12:15], v[40:43]
    v_mfma_f32_16x16x32_bf16 v[44:47], v[84:87], v[12:15], v[44:47]
    v_mfma_f32_16x16x32_bf16 v[40:43], v[72:75], v[16:19], v[40:43]
L_pad4:
    s_cbranch_execz L_touch_ret
    v_mfma_f32_16x16x32_bf16 v[44:47], v[88:91], v[16:19], v[44:47]
    v_mfma_f32_16x16x32_bf16 v[40:43], v[76:79], v[20:23], v[40:43]
    v_mfma_f32_16x16x32_bf16 v[44:47], v[92:95], v[20:23], v[44:47]
    s_nop 7
    s_mov_b32 s42, 0x3db504f3
    s_mov_b32 s46, 0x3db504f3
    v_cvt_pk_bf16_f32 v48, v40, v41
    v_cvt_pk_bf16_f32 v49, v42, v43
    v_cvt_pk_bf16_f32 v50, v44, v45
    v_cvt_pk_bf16_f32 v51, v46, v47
    v_lshlrev_b32 v40, 16, v48
    v_and_b32 v41, 0xffff0000, v48
    v_lshlrev_b32 v42, 16, v49
    v_and_b32 v43, 0xffff0000, v49
    v_lshlrev_b32 v44, 16, v50
    v_and_b32 v45, 0xffff0000, v50
    v_lshlrev_b32 v46, 16, v51
    v_and_b32 v47, 0xffff0000, v51
    v_mul_f32 v40, s42, v40
    v_mul_f32 v41, s42, v41
    v_mul_f32 v42, s42, v42
    v_mul_f32 v43, s42, v43
    v_mul_f32 v44, s42, v44
    v_mul_f32 v45, s42, v45
    v_mul_f32 v46, s42, v46
    v_mul_f32 v47, s42, v47
    v_cvt_pk_bf16_f32 v48, v40, v41
    v_cvt_pk_bf16_f32 v49, v42, v43
    v_cvt_pk_bf16_f32 v50, v44, v45
    v_cvt_pk_bf16_f32 v51, v46, v47
    v_lshlrev_b32 v40, 16, v48
    v_and_b32 v41, 0xffff0000, v48
    v_lshlrev_b32 v42, 16, v49
    v_and_b32 v43, 0xffff0000, v49
    v_lshlrev_b32 v44, 16, v50
    v_and_b32 v45, 0xffff0000, v50
    v_lshlrev_b32 v46, 16, v51
    v_and_b32 v47, 0xffff0000, v51
    v_max3_f32 v52, v40, v41, v42
    v_max3_f32 v53, v43, v44, v45
    v_max3_f32 v52, v52, v46, v47
    v_max_f32 v52, v52, v53
    v_mov_b32 v53, v52
    s_nop 1
    v_permlane16_swap_b32 v52, v53
    s_nop 0
    v_max_f32 v52, v52, v53
    v_mov_b32 v53, v52
    s_nop 1
    v_permlane32_swap_b32 v52, v53
    s_nop 0
    v_max_f32 v52, v52, v53
    s_mov_b64 exec, 15
    ds_write_b32 v115, v52 offset:64
    s_mov_b64 exec, 1
    ds_add_u32 v2, v4 offset:20
    s_mov_b64 exec, -1
    s_mov_b32 s42, 0x3fb8aa3b
L_wd12:
    ds_read_b32 v53, v2 offset:20
    ds_read_b128 v[56:59], v116 offset:64
    s_sub_u32 s6, s6, 1
    s_cbranch_scc1 L_exit
    s_waitcnt lgkmcnt(0)
    v_readfirstlane_b32 s58, v53
    s_cmp_ge_u32 s58, 4
    s_cbranch_scc0 L_wd12
    v_max3_f32 v52, v56, v57, v58
    v_max_f32 v52, v52, v59
    v_mul_f32 v53, s42, v52
    v_fma_f32 v40, v40, s42, -v53
    v_fma_f32 v41, v41, s42, -v53
    v_fma_f32 v42, v42, s42, -v53
    v_fma_f32 v43, v43, s42, -v53
    v_fma_f32 v44, v44, s42, -v53
    v_fma_f32 v45, v45, s42, -v53
    v_fma_f32 v46, v46, s42, -v53
    v_fma_f32 v47, v47, s42, -v53
    v_exp_f32 v40, v40
    v_exp_f32 v41, v41
    v_exp_f32 v42, v42
    v_exp_f32 v43, v43
    v_exp_f32 v44, v44
    v_exp_f32 v45, v45
    v_exp_f32 v46, v46
    v_exp_f32 v47, v47
    s_nop 0
    v_cvt_pk_bf16_f32 v48, v40, v41
    v_cvt_pk_bf16_f32 v49, v42, v43
    v_cvt_pk_bf16_f32 v50, v44, v45
    v_cvt_pk_bf16_f32 v51, v46, v47
    ds_write_b128 v117, v[48:51] offset:4096
    s_mov_b64 exec, 1
    ds_add_u32 v2, v4 offset:24
    s_mov_b64 exec, -1
    v_add_f32 v40, v40, v41
    v_add_f32 v42, v42, v43
    v_add_f32 v44, v44, v45
    v_add_f32 v46, v46, v47
    v_add_f32 v40, v40, v42
    v_add_f32 v44, v44, v46
    v_add_f32 v53, v40, v44
    v_mov_b32 v41, v53
    s_nop 1
    v_permlane16_swap_b32 v53, v41
    s_nop 0
    v_add_f32 v53, v53, v41
    v_mov_b32 v41, v53
    s_nop 1
    v_permlane32_swap_b32 v53, v41
    s_nop 0
    v_add_f32 v53, v53, v41
    s_mov_b64 exec, 15
    ds_write_b32 v115, v53 offset:128
    s_mov_b64 exec, 1
    ds_add_u32 v2, v4 offset:60
    s_mov_b64 exec, -1
    ds_read_b32 v40, v2 offset:8
    s_waitcnt lgkmcnt(0)
    v_readfirstlane_b32 s58, v40
    s_cmp_ge_u32 s58, 1
    s_cbranch_scc1 L_pvA14
L_wd16:
    ds_read_b32 v40, v2 offset:24
    ds_read_b128 v[8:11], v118 offset:4096
    ds_read_b128 v[12:15], v118 offset:5120
    ds_read_b128 v[16:19], v118 offset:6144
    ds_read_b128 v[20:23], v118 offset:7168
    s_sub_u32 s6, s6, 1
    s_cbranch_scc1 L_exit
    s_waitcnt lgkmcnt(0)
    v_readfirstlane_b32 s58, v40
    s_cmp_ge_u32 s58, 4
    s_cbranch_scc0 L_wd16
L_wf18:
    ds_read_b32 v40, v2 offset:8
    s_sub_u32 s6, s6, 1
    s_cbranch_scc1 L_exit
    s_waitcnt lgkmcnt(0)
    v_readfirstlane_b32 s58, v40
    s_cmp_ge_u32 s58, 1
    s_cbranch_scc0 L_wf18
    ds_read_b64_tr_b16 v[64:65], v119 offset:0
    ds_read_b64_tr_b16 v[66:67], v119 offset:4096
    ds_read_b64_tr_b16 v[80:81], v120 offset:0
    ds_read_b64_tr_b16 v[82:83], v120 offset:4096
    ds_read_b64_tr_b16 v[68:69], v119 offset:8192
    ds_read_b64_tr_b16 v[70:71], v119 offset:12288
    ds_read_b64_tr_b16 v[84:85], v120 offset:8192
    ds_read_b64_tr_b16 v[86:87], v120 offset:12288
    ds_read_b64_tr_b16 v[72:73], v119 offset:16384
    ds_read_b64_tr_b16 v[74:75], v119 offset:20480
    ds_read_b64_tr_b16 v[88:89], v120 offset:16384
    ds_read_b64_tr_b16 v[90:91], v120 offset:20480
    ds_read_b64_tr_b16 v[76:77], v119 offset:24576
    ds_read_b64_tr_b16 v[78:79], v119 offset:28672
    ds_read_b64_tr_b16 v[92:93], v120 offset:24576
    ds_read_b64_tr_b16 v[94:95], v120 offset:28672
    s_waitcnt lgkmcnt(12)
    v_mfma_f32_16x16x32_bf16 v[40:43], v[64:67], v[8:11], 0
    v_mfma_f32_16x16x32_bf16 v[44:47], v[80:83], v[8:11], 0
    s_waitcnt lgkmcnt(8)
    v_mfma_f32_16x16x32_bf16 v[40:43], v[68:71], v[12:15], v[40:43]
    v_mfma_f32_16x16x32_bf16 v[44:47], v[84:87], v[12:15], v[44:47]
    s_waitcnt lgkmcnt(4)
    v_mfma_f32_16x16x32_bf16 v[40:43], v[72:75], v[16:19], v[40:43]
    v_mfma_f32_16x16x32_bf16 v[44:47], v[88:91], v[16:19], v[44:47]
    s_waitcnt lgkmcnt(0)
    v_mfma_f32_16x16x32_bf16 v[40:43], v[76:79], v[20:23], v[40:43]
    v_mfma_f32_16x16x32_bf16 v[44:47], v[92:95], v[20:23], v[44:47]
    s_branch L_pvD15
L_pvA14:
    ds_read_b64_tr_b16 v[64:65], v119 offset:0
    ds_read_b64_tr_b16 v[66:67], v119 offset:4096
    ds_read_b64_tr_b16 v[80:81], v120 offset:0
    ds_read_b64_tr_b16 v[82:83], v120 offset:4096
    ds_read_b64_tr_b16 v[68:69], v119 offset:8192
L_pad5:
    s_cbranch_execz L_touch_ret2
    ds_read_b64_tr_b16 v[70:71], v119 offset:12288
    ds_read_b64_tr_b16 v[84:85], v120 offset:8192
    ds_read_b64_tr_b16 v[86:87], v120 offset:12288
    ds_read_b64_tr_b16 v[72:73], v119 offset:16384
    ds_read_b64_tr_b16 v[74:75], v119 offset:20480
    ds_read_b64_tr_b16 v[88:89], v120 offset:16384
    ds_read_b64_tr_b16 v[90:91], v120 offset:20480
    ds_read_b64_tr_b16 v[76:77], v119 offset:24576
    ds_read_b64_tr_b16 v[78:79], v119 offset:28672
    ds_read_b64_tr_b16 v[92:93], v120 offset:24576
    ds_read_b64_tr_b16 v[94:95], v120 offset:28672
L_wd19:
    ds_read_b32 v40, v2 offset:24
    ds_read_b128 v[8:11], v118 offset:4096
    ds_read_b128 v[12:15], v118 offset:5120
    ds_read_b128 v[16:19], v118 offset:6144
    ds_read_b128 v[20:23], v118 offset:7168
    s_sub_u32 s6, s6, 1
    s_cbranch_scc1 L_exit
    s_waitcnt lgkmcnt(0)
    v_readfirstlane_b32 s58, v40
    s_cmp_ge_u32 s58, 4
    s_cbranch_scc0 L_wd19
    v_mfma_f32_16x16x32_bf16 v[40:43], v[64:67], v[8:11], 0
    v_mfma_f32_16x16x32_bf16 v[44:47], v[80:83], v[8:11], 0
    v_mfma_f32_16x16x32_bf16 v[40:43], v[68:71], v[12:15], v[40:43]
    v_mfma_f32_16x16x32_bf16 v[44:47], v[84:87], v[12:15], v[44:47]
    v_mfma_f32_16x16x32_bf16 v[40:43], v[72:75], v[16:19], v[40:43]
    v_mfma_f32_16x16x32_bf16 v[44:47], v[88:91], v[16:19], v[44:47]
    v_mfma_f32_16x16x32_bf16 v[40:43], v[76:79], v[20:23], v[40:43]
    v_mfma_f32_16x16x32_bf16 v[44:47], v[92:95], v[20:23], v[44:47]
L_pvD15:
    s_mov_b32 exec_lo, 0x00ff00ff
    s_mov_b32 exec_hi, 0x00ff00ff
    s_nop 5
    v_cndmask_b32 v100, v40, v44, s[50:51]
    v_cndmask_b32 v101, v41, v45, s[50:51]
    v_cndmask_b32 v102, v42, v46, s[50:51]
    v_cndmask_b32 v103, v43, v47, s[50:51]
    v_and_or_b32 v100, v100, s43, v6
    v_and_or_b32 v101, v101, s43, v6
    v_and_or_b32 v102, v102, s43, v6
    v_and_or_b32 v103, v103, s43, v6
    buffer_store_dwordx4 v[100:103], v121, s[92:95], 0 offen
    s_mov_b64 exec, -1
    buffer_load_dwordx4 v[64:67], v122, s[92:95], 0 offen sc1
    buffer_load_dwordx4 v[68:71], v122, s[92:95], s60 offen sc1
    buffer_load_dwordx4 v[72:75], v122, s[92:95], s61 offen sc1
    buffer_load_dwordx4 v[76:79], v122, s[92:95], s62 offen sc1
L_wf24:
    ds_read_b32 v32, v2 offset:12
    s_sub_u32 s6, s6, 1
    s_cbranch_scc1 L_exit
    s_waitcnt lgkmcnt(0)
    v_readfirstlane_b32 s58, v32
    s_cmp_ge_u32 s58, 1
    s_cbranch_scc0 L_wf24
    ds_read_b64_tr_b16 v[80:81], v105 offset:0
    ds_read_b64_tr_b16 v[82:83], v105 offset:2048
    ds_read_b64_tr_b16 v[84:85], v105 offset:4096
    ds_read_b64_tr_b16 v[86:87], v105 offset:6144
    ds_read_b64_tr_b16 v[88:89], v105 offset:8192
    ds_read_b64_tr_b16 v[90:91], v105 offset:10240
    ds_read_b64_tr_b16 v[92:93], v105 offset:12288
    ds_read_b64_tr_b16 v[94:95], v105 offset:14336
    s_mov_b32 s46, 0
    s_mov_b32 s57, 0
L_op21:
    s_cmp_lg_u32 s57, 0
    s_cbranch_scc1 L_opW25
    ds_read_b32 v32, v2 offset:28
    ds_read_b32 v33, v123 offset:1408
    ds_read_b32 v34, v123 offset:1440
    ds_read_b32 v35, v123 offset:1472
    ds_read_b32 v36, v123 offset:1504
    s_waitcnt lgkmcnt(0)
    v_readfirstlane_b32 s57, v32
L_opW25:
    s_waitcnt vmcnt(0)
    v_perm_b32 v40, v65, v64, s44
    v_perm_b32 v41, v67, v66, s45
    v_perm_b32 v42, v69, v68, s44
    v_perm_b32 v43, v71, v70, s45
    v_perm_b32 v44, v73, v72, s44
    v_perm_b32 v45, v75, v74, s45
    v_perm_b32 v46, v77, v76, s44
    v_perm_b32 v47, v79, v78, s45
    v_or_b32 v40, v40, v41
    v_or_b32 v42, v42, v43
    v_or_b32 v44, v44, v45
    v_or_b32 v46, v46, v47
    v_cmp_ne_u32 s[48:49], s41, v40
    v_cmp_ne_u32 s[52:53], s41, v42
    v_cmp_ne_u32 s[54:55], s41, v44
    v_cmp_ne_u32 s[96:97], s41, v46
    s_or_b64 vcc, s[48:49], s[52:53]
    s_or_b64 s[98:99], s[54:55], s[96:97]
    s_or_b64 vcc, vcc, s[98:99]
    s_cbranch_scc0 L_opk22
    s_add_u32 s46, s46, 1
    s_cmp_eq_u32 s46, 18
    s_cbranch_scc0 L_opN23
    s_mov_b32 exec_lo, 0x00010001
    s_mov_b32 exec_hi, 0x00010001
    buffer_store_dwordx4 v[96:99], v106, s[92:95], 0 offen sc1
    s_mov_b32 exec_lo, 0x00ff00ff
    s_mov_b32 exec_hi, 0x00ff00ff
    buffer_store_dwordx4 v[100:103], v121, s[92:95], 0 offen sc1
    s_mov_b64 exec, -1
L_opN23:
    s_mov_b64 exec, s[48:49]
    s_cbranch_execz L_opS26
    buffer_load_dwordx4 v[64:67], v122, s[92:95], 0 offen sc1
L_opS26:
    s_mov_b64 exec, s[52:53]
    s_cbranch_execz L_opS27
    buffer_load_dwordx4 v[68:71], v122, s[92:95], s60 offen sc1
L_opS27:
    s_mov_b64 exec, s[54:55]
    s_cbranch_execz L_opS28
    buffer_load_dwordx4 v[72:75], v122, s[92:95], s61 offen sc1
L_opS28:
    s_mov_b64 exec, s[96:97]
    s_cbranch_execz L_opS29
    buffer_load_dwordx4 v[76:79], v122, s[92:95], s62 offen sc1
L_opS29:
    s_mov_b64 exec, -1
    s_cmp_lt_u32 s46, 32768
    s_cbranch_scc1 L_op21
L_opk22:
    v_and_b32 v64, s43, v64
    v_and_b32 v65, s43, v65
    v_and_b32 v66, s43, v66
    v_and_b32 v67, s43, v67
    v_and_b32 v68, s43, v68
    v_and_b32 v69, s43, v69
    v_and_b32 v70, s43, v70
    v_and_b32 v71, s43, v71
    v_and_b32 v72, s43, v72
    v_and_b32 v73, s43, v73
    v_and_b32 v74, s43, v74
    v_and_b32 v75, s43, v75
    v_and_b32 v76, s43, v76
    v_and_b32 v77, s43, v77
    v_and_b32 v78, s43, v78
    v_and_b32 v79, s43, v79
    s_cmp_lg_u32 s57, 0
    s_cbranch_scc1 L_wwG32
    s_mov_b32 s46, 0
L_ww30:
    ds_read_b32 v32, v2 offset:28
    ds_read_b32 v33, v123 offset:1408
    ds_read_b32 v34, v123 offset:1440
    ds_read_b32 v35, v123 offset:1472
    ds_read_b32 v36, v123 offset:1504
    s_add_u32 s46, s46, 1
    s_cmp_eq_u32 s46, 72
    s_cbranch_scc0 L_wwN31
    s_mov_b32 exec_lo, 0x00010001
    s_mov_b32 exec_hi, 0x00010001
    buffer_store_dwordx4 v[96:99], v106, s[92:95], 0 offen sc1
    s_mov_b32 exec_lo, 0x00ff00ff
    s_mov_b32 exec_hi, 0x00ff00ff
    buffer_store_dwordx4 v[100:103], v121, s[92:95], 0 offen sc1
    s_mov_b64 exec, -1
L_wwN31:
    s_sub_u32 s6, s6, 1
    s_cbranch_scc1 L_exit
    s_waitcnt lgkmcnt(0)
    v_readfirstlane_b32 s57, v32
    s_cmp_lg_u32 s57, 0
    s_cbranch_scc0 L_ww30
L_wwG32:
    v_mul_f32 v40, v33, v64
    v_mul_f32 v41, v33, v65
    v_mul_f32 v42, v33, v66
    v_mul_f32 v43, v33, v67
    v_fmac_f32 v40, v34, v68
    v_fmac_f32 v41, v34, v69
    v_fmac_f32 v42, v34, v70
L_pad6:
    s_cbranch_execz L_touch_ret2
    v_fmac_f32 v43, v34, v71
    v_fmac_f32 v40, v35, v72
    v_fmac_f32 v41, v35, v73
    v_fmac_f32 v42, v35, v74
    v_fmac_f32 v43, v35, v75
    v_fmac_f32 v40, v36, v76
    v_fmac_f32 v41, v36, v77
    v_fmac_f32 v42, v36, v78
    v_fmac_f32 v43, v36, v79
    s_nop 0
    v_permlane32_swap_b32 v40, v42
    v_permlane32_swap_b32 v41, v43
    v_add_f32 v40, v40, v42
    v_add_f32 v41, v41, v43
    s_nop 1
    v_permlane16_swap_b32 v40, v41
    v_add_f32 v40, v40, v41
    s_nop 1
    v_add_f32_dpp v40, v40, v40 row_ror:8 row_mask:0xf bank_mask:0xf
    v_cvt_pk_bf16_f32 v40, v40, v40
    ds_write_b16 v125, v40 offset:1536
    s_mov_b64 exec, 1
    ds_add_u32 v2, v4 offset:32
    s_mov_b64 exec, -1
    s_mov_b32 s63, 0
L_wd33:
    ds_read_b32 v32, v2 offset:32
    ds_read2_b64 v[8:11], v126 offset0:192 offset1:196
    ds_read2_b64 v[12:15], v126 offset0:200 offset1:204
    ds_read2_b64 v[16:19], v126 offset0:208 offset1:212
    ds_read2_b64 v[20:23], v126 offset0:216 offset1:220
    s_add_u32 s63, s63, 1
    s_cmp_eq_u32 s63, 70
    s_cbranch_scc0 L_wdN34
    s_mov_b32 exec_lo, 0x00010001
    s_mov_b32 exec_hi, 0x00010001
    buffer_store_dwordx4 v[96:99], v106, s[92:95], 0 offen sc1
    s_mov_b32 exec_lo, 0x00ff00ff
    s_mov_b32 exec_hi, 0x00ff00ff
    buffer_store_dwordx4 v[100:103], v121, s[92:95], 0 offen sc1
    s_mov_b64 exec, -1
L_wdN34:
    s_sub_u32 s6, s6, 1
    s_cbranch_scc1 L_exit
    s_waitcnt lgkmcnt(0)
    v_readfirstlane_b32 s58, v32
    s_cmp_ge_u32 s58, 4
    s_cbranch_scc0 L_wd33
    v_mfma_f32_16x16x32_bf16 v[48:51], v[80:83], v[8:11], 0
    v_mfma_f32_16x16x32_bf16 v[48:51], v[84:87], v[12:15], v[48:51]
    v_mfma_f32_16x16x32_bf16 v[48:51], v[88:91], v[16:19], v[48:51]
    v_mfma_f32_16x16x32_bf16 v[48:51], v[92:95], v[20:23], v[48:51]
    s_mov_b32 exec_lo, 0x00010001
    s_mov_b32 exec_hi, 0x00010001
    s_nop 5
    v_and_or_b32 v48, v48, s43, v6
    v_and_or_b32 v49, v49, s43, v6
    v_and_or_b32 v50, v50, s43, v6
    v_and_or_b32 v51, v51, s43, v6
    buffer_store_dwordx4 v[48:51], v124, s[92:95], 0 offen sc1
    s_mov_b64 exec, -1
    s_cmp_eq_u32 s57, 1
    s_cbranch_scc1 L_same35
    s_mov_b32 exec_lo, 0x00010001
    s_mov_b32 exec_hi, 0x00010001
    buffer_store_dwordx4 v[96:99], v106, s[92:95], 0 offen sc1
    s_mov_b32 exec_lo, 0x00ff00ff
    s_mov_b32 exec_hi, 0x00ff00ff
    buffer_store_dwordx4 v[100:103], v121, s[92:95], 0 offen sc1
    s_mov_b64 exec, -1
L_same35:
    s_endpgm
L_aux:
    s_lshl_b32 s34, s5, 4
    s_lshl_b32 s35, s4, 1
    s_add_u32 s34, s34, s35
    s_lshl_b32 s35, s34, 1
    v_mov_b32 v3, s35
    s_waitcnt lgkmcnt(0)
    ds_read_b32 v4, v3 offset:3072
    s_waitcnt vmcnt(0) lgkmcnt(0)
    v_lshlrev_b32 v6, 16, v4
    v_and_b32 v7, 0xffff0000, v4
    v_mov_b32 v8, 0
    v_mov_b32 v9, 0
    s_mov_b32 s42, 0x40135761
    s_mov_b32 s43, 0x40135761
    s_mov_b32 s44, 0x3dd2d3e8
    s_mov_b32 s45, 0x3dd2d3e8
    v_mov_b32 v10, s42
    v_mov_b32 v11, s42
    v_lshlrev_b32 v12, 16, v28
    v_and_b32 v13, 0xffff0000, v28
    v_lshlrev_b32 v14, 16, v32
    v_and_b32 v15, 0xffff0000, v32
    v_lshlrev_b32 v16, 16, v36
    v_and_b32 v17, 0xffff0000, v36
    v_pk_mul_f32 v[40:41], v[6:7], v[12:13] op_sel_hi:[1,0]
    v_pk_mul_f32 v[50:51], v[6:7], v[12:13] op_sel:[0,1]
    v_cvt_pk_bf16_f32 v42, v40, v41
    v_cvt_pk_bf16_f32 v52, v50, v51
    v_lshlrev_b32 v40, 16, v42
    v_and_b32 v41, 0xffff0000, v42
    v_lshlrev_b32 v50, 16, v52
    v_and_b32 v51, 0xffff0000, v52
    v_pk_add_f32 v[40:41], v[40:41], v[14:15] op_sel_hi:[1,0]
    v_pk_add_f32 v[50:51], v[50:51], v[14:15] op_sel:[0,1]
    v_cvt_pk_bf16_f32 v42, v40, v41
    v_cvt_pk_bf16_f32 v52, v50, v51
    v_lshlrev_b32 v40, 16, v42
    v_and_b32 v41, 0xffff0000, v42
    v_lshlrev_b32 v50, 16, v52
    v_and_b32 v51, 0xffff0000, v52
    v_pk_mul_f32 v[42:43], v[40:41], v[40:41]
    v_pk_mul_f32 v[52:53], v[50:51], v[50:51]
    v_pk_fma_f32 v[42:43], v[42:43], s[44:45], v[10:11]
    v_pk_fma_f32 v[52:53], v[52:53], s[44:45], v[10:11]
    v_pk_mul_f32 v[42:43], v[42:43], v[40:41]
    v_pk_mul_f32 v[52:53], v[52:53], v[50:51]
    v_exp_f32 v42, -v42
    v_exp_f32 v43, -v43
    v_exp_f32 v52, -v52
    v_exp_f32 v53, -v53
    v_pk_add_f32 v[42:43], v[42:43], 1.0 op_sel_hi:[1,0]
    v_pk_add_f32 v[52:53], v[52:53], 1.0 op_sel_hi:[1,0]
    v_rcp_f32 v42, v42
    v_rcp_f32 v43, v43
    v_rcp_f32 v52, v52
    v_rcp_f32 v53, v53
    v_pk_mul_f32 v[40:41], v[40:41], v[42:43]
    v_pk_mul_f32 v[50:51], v[50:51], v[52:53]
    v_cvt_pk_bf16_f32 v42, v40, v41
    v_cvt_pk_bf16_f32 v52, v50, v51
    v_lshlrev_b32 v40, 16, v42
    v_and_b32 v41, 0xffff0000, v42
    v_lshlrev_b32 v50, 16, v52
    v_and_b32 v51, 0xffff0000, v52
    v_pk_fma_f32 v[8:9], v[40:41], v[16:17], v[8:9] op_sel_hi:[1,0,1]
    v_pk_fma_f32 v[8:9], v[50:51], v[16:17], v[8:9] op_sel:[0,1,0]
    v_lshlrev_b32 v12, 16, v29
    v_and_b32 v13, 0xffff0000, v29
    v_lshlrev_b32 v14, 16, v33
    v_and_b32 v15, 0xffff0000, v33
    v_lshlrev_b32 v16, 16, v37
    v_and_b32 v17, 0xffff0000, v37
    v_pk_mul_f32 v[40:41], v[6:7], v[12:13] op_sel_hi:[1,0]
    v_pk_mul_f32 v[50:51], v[6:7], v[12:13] op_sel:[0,1]
    v_cvt_pk_bf16_f32 v42, v40, v41
    v_cvt_pk_bf16_f32 v52, v50, v51
    v_lshlrev_b32 v40, 16, v42
    v_and_b32 v41, 0xffff0000, v42
    v_lshlrev_b32 v50, 16, v52
    v_and_b32 v51, 0xffff0000, v52
    v_pk_add_f32 v[40:41], v[40:41], v[14:15] op_sel_hi:[1,0]
    v_pk_add_f32 v[50:51], v[50:51], v[14:15] op_sel:[0,1]
    v_cvt_pk_bf16_f32 v42, v40, v41
    v_cvt_pk_bf16_f32 v52, v50, v51
    v_lshlrev_b32 v40, 16, v42
    v_and_b32 v41, 0xffff0000, v42
    v_lshlrev_b32 v50, 16, v52
    v_and_b32 v51, 0xffff0000, v52
    v_pk_mul_f32 v[42:43], v[40:41], v[40:41]
    v_pk_mul_f32 v[52:53], v[50:51], v[50:51]
    v_pk_fma_f32 v[42:43], v[42:43], s[44:45], v[10:11]
    v_pk_fma_f32 v[52:53], v[52:53], s[44:45], v[10:11]
    v_pk_mul_f32 v[42:43], v[42:43], v[40:41]
L_pad7:
    s_cbranch_execz L_touch_ret2
    v_pk_mul_f32 v[52:53], v[52:53], v[50:51]
    v_exp_f32 v42, -v42
    v_exp_f32 v43, -v43
    v_exp_f32 v52, -v52
    v_exp_f32 v53, -v53
    v_pk_add_f32 v[42:43], v[42:43], 1.0 op_sel_hi:[1,0]
    v_pk_add_f32 v[52:53], v[52:53], 1.0 op_sel_hi:[1,0]
    v_rcp_f32 v42, v42
    v_rcp_f32 v43, v43
    v_rcp_f32 v52, v52
    v_rcp_f32 v53, v53
    v_pk_mul_f32 v[40:41], v[40:41], v[42:43]
    v_pk_mul_f32 v[50:51], v[50:51], v[52:53]
    v_cvt_pk_bf16_f32 v42, v40, v41
    v_cvt_pk_bf16_f32 v52, v50, v51
    v_lshlrev_b32 v40, 16, v42
    v_and_b32 v41, 0xffff0000, v42
    v_lshlrev_b32 v50, 16, v52
    v_and_b32 v51, 0xffff0000, v52
    v_pk_fma_f32 v[8:9], v[40:41], v[16:17], v[8:9] op_sel_hi:[1,0,1]
    v_pk_fma_f32 v[8:9], v[50:51], v[16:17], v[8:9] op_sel:[0,1,0]
    v_lshlrev_b32 v12, 16, v30
    v_and_b32 v13, 0xffff0000, v30
    v_lshlrev_b32 v14, 16, v34
    v_and_b32 v15, 0xffff0000, v34
    v_lshlrev_b32 v16, 16, v38
    v_and_b32 v17, 0xffff0000, v38
    v_pk_mul_f32 v[40:41], v[6:7], v[12:13] op_sel_hi:[1,0]
    v_pk_mul_f32 v[50:51], v[6:7], v[12:13] op_sel:[0,1]
    v_cvt_pk_bf16_f32 v42, v40, v41
    v_cvt_pk_bf16_f32 v52, v50, v51
    v_lshlrev_b32 v40, 16, v42
    v_and_b32 v41, 0xffff0000, v42
    v_lshlrev_b32 v50, 16, v52
    v_and_b32 v51, 0xffff0000, v52
    v_pk_add_f32 v[40:41], v[40:41], v[14:15] op_sel_hi:[1,0]
    v_pk_add_f32 v[50:51], v[50:51], v[14:15] op_sel:[0,1]
    v_cvt_pk_bf16_f32 v42, v40, v41
    v_cvt_pk_bf16_f32 v52, v50, v51
    v_lshlrev_b32 v40, 16, v42
    v_and_b32 v41, 0xffff0000, v42
    v_lshlrev_b32 v50, 16, v52
    v_and_b32 v51, 0xffff0000, v52
    v_pk_mul_f32 v[42:43], v[40:41], v[40:41]
    v_pk_mul_f32 v[52:53], v[50:51], v[50:51]
    v_pk_fma_f32 v[42:43], v[42:43], s[44:45], v[10:11]
    v_pk_fma_f32 v[52:53], v[52:53], s[44:45], v[10:11]
    v_pk_mul_f32 v[42:43], v[42:43], v[40:41]
    v_pk_mul_f32 v[52:53], v[52:53], v[50:51]
    v_exp_f32 v42, -v42
    v_exp_f32 v43, -v43
    v_exp_f32 v52, -v52
    v_exp_f32 v53, -v53
    v_pk_add_f32 v[42:43], v[42:43], 1.0 op_sel_hi:[1,0]
    v_pk_add_f32 v[52:53], v[52:53], 1.0 op_sel_hi:[1,0]
    v_rcp_f32 v42, v42
    v_rcp_f32 v43, v43
    v_rcp_f32 v52, v52
    v_rcp_f32 v53, v53
    v_pk_mul_f32 v[40:41], v[40:41], v[42:43]
    v_pk_mul_f32 v[50:51], v[50:51], v[52:53]
    v_cvt_pk_bf16_f32 v42, v40, v41
    v_cvt_pk_bf16_f32 v52, v50, v51
    v_lshlrev_b32 v40, 16, v42
    v_and_b32 v41, 0xffff0000, v42
    v_lshlrev_b32 v50, 16, v52
    v_and_b32 v51, 0xffff0000, v52
    v_pk_fma_f32 v[8:9], v[40:41], v[16:17], v[8:9] op_sel_hi:[1,0,1]
    v_pk_fma_f32 v[8:9], v[50:51], v[16:17], v[8:9] op_sel:[0,1,0]
    v_lshlrev_b32 v12, 16, v31
    v_and_b32 v13, 0xffff0000, v31
    v_lshlrev_b32 v14, 16, v35
    v_and_b32 v15, 0xffff0000, v35
    v_lshlrev_b32 v16, 16, v39
    v_and_b32 v17, 0xffff0000, v39
    v_pk_mul_f32 v[40:41], v[6:7], v[12:13] op_sel_hi:[1,0]
    v_pk_mul_f32 v[50:51], v[6:7], v[12:13] op_sel:[0,1]
    v_cvt_pk_bf16_f32 v42, v40, v41
    v_cvt_pk_bf16_f32 v52, v50, v51
    v_lshlrev_b32 v40, 16, v42
    v_and_b32 v41, 0xffff0000, v42
    v_lshlrev_b32 v50, 16, v52
    v_and_b32 v51, 0xffff0000, v52
    v_pk_add_f32 v[40:41], v[40:41], v[14:15] op_sel_hi:[1,0]
    v_pk_add_f32 v[50:51], v[50:51], v[14:15] op_sel:[0,1]
    v_cvt_pk_bf16_f32 v42, v40, v41
    v_cvt_pk_bf16_f32 v52, v50, v51
    v_lshlrev_b32 v40, 16, v42
    v_and_b32 v41, 0xffff0000, v42
    v_lshlrev_b32 v50, 16, v52
    v_and_b32 v51, 0xffff0000, v52
    v_pk_mul_f32 v[42:43], v[40:41], v[40:41]
    v_pk_mul_f32 v[52:53], v[50:51], v[50:51]
    v_pk_fma_f32 v[42:43], v[42:43], s[44:45], v[10:11]
    v_pk_fma_f32 v[52:53], v[52:53], s[44:45], v[10:11]
    v_pk_mul_f32 v[42:43], v[42:43], v[40:41]
    v_pk_mul_f32 v[52:53], v[52:53], v[50:51]
    v_exp_f32 v42, -v42
    v_exp_f32 v43, -v43
    v_exp_f32 v52, -v52
    v_exp_f32 v53, -v53
    v_pk_add_f32 v[42:43], v[42:43], 1.0 op_sel_hi:[1,0]
    v_pk_add_f32 v[52:53], v[52:53], 1.0 op_sel_hi:[1,0]
    v_rcp_f32 v42, v42
    v_rcp_f32 v43, v43
    v_rcp_f32 v52, v52
    v_rcp_f32 v53, v53
    v_pk_mul_f32 v[40:41], v[40:41], v[42:43]
    v_pk_mul_f32 v[50:51], v[50:51], v[52:53]
    v_cvt_pk_bf16_f32 v42, v40, v41
    v_cvt_pk_bf16_f32 v52, v50, v51
    v_lshlrev_b32 v40, 16, v42
    v_and_b32 v41, 0xffff0000, v42
    v_lshlrev_b32 v50, 16, v52
    v_and_b32 v51, 0xffff0000, v52
    v_pk_fma_f32 v[8:9], v[40:41], v[16:17], v[8:9] op_sel_hi:[1,0,1]
    v_pk_fma_f32 v[8:9], v[50:51], v[16:17], v[8:9] op_sel:[0,1,0]
    s_nop 1
    v_add_f32_dpp v8, v8, v8 quad_perm:[1,0,3,2] row_mask:0xf bank_mask:0xf
    v_add_f32_dpp v9, v9, v9 quad_perm:[1,0,3,2] row_mask:0xf bank_mask:0xf
    s_nop 1
    v_add_f32_dpp v8, v8, v8 quad_perm:[2,3,0,1] row_mask:0xf bank_mask:0xf
    v_add_f32_dpp v9, v9, v9 quad_perm:[2,3,0,1] row_mask:0xf bank_mask:0xf
    s_nop 1
    v_add_f32_dpp v8, v8, v8 row_half_mirror row_mask:0xf bank_mask:0xf
    v_add_f32_dpp v9, v9, v9 row_half_mirror row_mask:0xf bank_mask:0xf
    s_nop 1
    v_add_f32_dpp v8, v8, v8 row_mirror row_mask:0xf bank_mask:0xf
    v_add_f32_dpp v9, v9, v9 row_mirror row_mask:0xf bank_mask:0xf
    v_mov_b32 v12, v8
    v_mov_b32 v13, v9
    s_nop 1
    v_permlane16_swap_b32 v8, v12
    v_permlane16_swap_b32 v9, v13
    v_add_f32 v8, v8, v12
    v_add_f32 v9, v9, v13
    v_mov_b32 v12, v8
    v_mov_b32 v13, v9
    s_nop 1
    v_permlane32_swap_b32 v8, v12
    v_permlane32_swap_b32 v9, v13
    v_add_f32 v8, v8, v12
    v_add_f32 v9, v9, v13
    s_sub_u32 s35, s3, 4
    s_lshl_b32 s35, s35, 3
    v_mov_b32 v12, s35
    v_mov_b32 v13, 1
    s_mov_b64 exec, 1
    ds_write_b64 v12, v[8:9] offset:192
    ds_add_u32 v2, v13 offset:36
    s_mov_b64 exec, -1
    s_cmp_eq_u32 s3, 4
    s_cbranch_scc1 L_tail
    s_endpgm
L_tail:
    s_setprio 2
    s_lshl_b32 s35, s34, 1
    v_mov_b32 v3, s35
    global_load_dword v20, v3, s[8:9]
L_pad8:
    s_cbranch_execz L_touch_ret2
    global_load_ushort v21, v2, s[26:27]
    v_and_b32 v1, 31, v0
    s_lshl_b32 s42, s4, 11
    s_lshr_b32 s43, s5, 3
    s_lshl_b32 s43, s43, 9
    s_add_u32 s42, s42, s43
    s_add_u32 s42, s42, 0x00012000
    v_lshl_add_u32 v4, v1, 4, s42
    buffer_load_dwordx4 v[24:27], v4, s[92:95], 0 offen sc1
    s_lshl_b32 s42, s5, 11
    s_lshr_b32 s43, s4, 1
    s_lshl_b32 s43, s43, 4
    s_add_u32 s42, s42, s43
    s_add_u32 s42, s42, 0x00018000
    v_lshl_add_u32 v7, v1, 6, s42
    v_lshlrev_b32 v5, 2, v1
    s_mov_b32 s44, 0x0c0c0400
    s_mov_b32 s45, 0x04000c0c
    s_mov_b32 s47, 0xffffff00
L_wf36:
    s_sleep 1
    ds_read_b32 v9, v2 offset:36
    s_sub_u32 s6, s6, 1
    s_cbranch_scc1 L_exit
    s_waitcnt lgkmcnt(0)
    v_readfirstlane_b32 s58, v9
    s_cmp_ge_u32 s58, 4
    s_cbranch_scc0 L_wf36
    ds_read_b128 v[12:15], v2 offset:192
    ds_read_b128 v[16:19], v2 offset:208
    s_waitcnt lgkmcnt(0)
    v_add_f32 v12, v12, v14
    v_add_f32 v13, v13, v15
    v_add_f32 v16, v16, v18
    v_add_f32 v17, v17, v19
    v_add_f32 v12, v12, v16
    v_add_f32 v13, v13, v17
    v_cvt_pk_bf16_f32 v12, v12, v13
    v_and_b32 v13, 0xffff0000, v12
    v_lshlrev_b32 v12, 16, v12
    s_waitcnt vmcnt(1)
    v_lshlrev_b32 v21, 16, v21
    v_add_f32 v12, v12, v21
    v_add_f32 v13, v13, v21
    v_cvt_pk_bf16_f32 v12, v12, v13
    v_and_b32 v13, 0xffff0000, v12
    v_lshlrev_b32 v12, 16, v12
    v_mul_f32 v14, 0xbfb8aa3b, v12
    v_mul_f32 v15, 0xbfb8aa3b, v13
    v_exp_f32 v14, v14
    v_exp_f32 v15, v15
    s_nop 0
    v_add_f32 v14, 1.0, v14
    v_add_f32 v15, 1.0, v15
    v_rcp_f32 v14, v14
    v_rcp_f32 v15, v15
    s_nop 0
    v_mul_f32 v12, v12, v14
    v_mul_f32 v13, v13, v15
    v_cvt_pk_bf16_f32 v12, v12, v13
    v_and_b32 v13, 0xffff0000, v12
    v_lshlrev_b32 v12, 16, v12
    v_and_b32 v11, 0xffff0000, v20
    v_lshlrev_b32 v10, 16, v20
    v_and_b32 v9, 3, v0
    v_lshlrev_b32 v14, 4, v9
    s_lshl_b32 s42, s4, 11
    s_lshl_b32 s43, s5, 4
    s_add_u32 s42, s42, s43
    s_add_u32 s42, s42, 0x00012000
    v_lshl_add_u32 v15, v9, 9, s42
    s_getreg_b32 s42, hwreg(HW_REG_XCC_ID)
    s_and_b32 s42, s42, 15
    s_lshl_b32 s42, s42, 8
    s_or_b32 s56, s42, s40
    v_mov_b32 v8, s40
    v_mov_b32 v18, s56
L_wd37:
    ds_read_b32 v9, v2 offset:60
    ds_read_b128 v[32:35], v14 offset:64
    ds_read_b128 v[36:39], v14 offset:128
    s_sub_u32 s6, s6, 1
    s_cbranch_scc1 L_exit
    s_waitcnt lgkmcnt(0)
    v_readfirstlane_b32 s58, v9
    s_cmp_ge_u32 s58, 4
    s_cbranch_scc0 L_wd37
    v_max3_f32 v16, v32, v33, v34
    v_add_f32 v36, v36, v37
    v_add_f32 v38, v38, v39
    v_max_f32 v16, v16, v35
    v_add_f32 v17, v36, v38
    v_and_or_b32 v16, v16, s47, v8
    v_and_or_b32 v17, v17, s47, v8
    v_mov_b32 v19, v17
    s_mov_b64 exec, 15
    buffer_store_dwordx4 v[16:19], v15, s[92:95], 0 offen
    s_mov_b64 exec, -1
    s_mov_b32 s46, 0
L_mpoll39:
    buffer_load_dwordx4 v[24:27], v4, s[92:95], 0 offen sc1
    s_add_u32 s46, s46, 1
    s_cmp_eq_u32 s46, 14
    s_cbranch_scc0 L_mnr41
    s_mov_b64 exec, 15
    buffer_store_dwordx4 v[16:19], v15, s[92:95], 0 offen sc1
    s_mov_b64 exec, -1
L_mnr41:
    s_waitcnt vmcnt(0)
    v_perm_b32 v40, v25, v24, s44
    v_perm_b32 v41, v27, v26, s45
    v_or_b32 v40, v40, v41
    v_cmp_eq_u32 vcc, s41, v40
    s_cmp_eq_u64 vcc, -1
    s_cbranch_scc1 L_mok40
    s_cmp_lt_u32 s46, 32768
    s_cbranch_scc1 L_mpoll39
L_mok40:
    v_cmp_eq_u32 vcc, s56, v26
    v_and_b32 v24, s47, v24
    v_and_b32 v25, s47, v25
    s_cmp_eq_u64 vcc, -1
    s_cselect_b32 s59, 1, 2
    v_mov_b32 v28, v24
    s_nop 1
    v_max_f32_dpp v28, v28, v28 quad_perm:[1,0,3,2] row_mask:0xf bank_mask:0xf
    s_nop 1
    v_max_f32_dpp v28, v28, v28 quad_perm:[2,3,0,1] row_mask:0xf bank_mask:0xf
    s_nop 1
    v_max_f32_dpp v28, v28, v28 row_half_mirror row_mask:0xf bank_mask:0xf
    s_nop 1
    v_max_f32_dpp v28, v28, v28 row_mirror row_mask:0xf bank_mask:0xf
    v_mov_b32 v29, v28
    s_nop 1
    v_permlane16_swap_b32 v28, v29
    v_max_f32 v28, v28, v29
    s_mov_b32 s42, 0x3fb8aa3b
    v_mul_f32 v28, s42, v28
    v_fma_f32 v24, v24, s42, -v28
    v_exp_f32 v24, v24
    s_nop 0
    v_mul_f32 v25, v24, v25
    s_nop 1
    v_add_f32_dpp v25, v25, v25 quad_perm:[1,0,3,2] row_mask:0xf bank_mask:0xf
    s_nop 1
    v_add_f32_dpp v25, v25, v25 quad_perm:[2,3,0,1] row_mask:0xf bank_mask:0xf
    s_nop 1
    v_add_f32_dpp v25, v25, v25 row_half_mirror row_mask:0xf bank_mask:0xf
    s_nop 1
    v_add_f32_dpp v25, v25, v25 row_mirror row_mask:0xf bank_mask:0xf
    v_mov_b32 v29, v25
    s_nop 1
    v_permlane16_swap_b32 v25, v29
    v_add_f32 v25, v25, v29
    v_rcp_f32 v25, v25
    v_mov_b32 v57, s59
    v_mul_f32 v24, v24, v25
    ds_write_b32 v5, v24 offset:1408
    s_mov_b64 exec, 1
    ds_write_b32 v2, v57 offset:28
    s_mov_b64 exec, -1
    s_cmp_eq_u32 s59, 1
    s_cbranch_scc1 L_tail_same
    s_mov_b64 exec, 15
    buffer_store_dwordx4 v[16:19], v15, s[92:95], 0 offen sc1
    s_mov_b64 exec, -1
L_tail_same:
L_wf42:
    s_sleep 1
    ds_read_b32 v9, v2 offset:32
    s_sub_u32 s6, s6, 1
    s_cbranch_scc1 L_exit
    s_waitcnt lgkmcnt(0)
    v_readfirstlane_b32 s58, v9
    s_cmp_ge_u32 s58, 4
    s_cbranch_scc0 L_wf42
    s_mov_b32 s46, 0
L_gpoll43:
    buffer_load_dwordx4 v[28:31], v7, s[92:95], 0 offen sc1
    s_add_u32 s46, s46, 1
    s_waitcnt vmcnt(0)
    v_perm_b32 v40, v29, v28, s44
    v_perm_b32 v41, v31, v30, s45
    v_or_b32 v40, v40, v41
    v_cmp_eq_u32 vcc, s41, v40
    s_cmp_eq_u64 vcc, -1
    s_cbranch_scc1 L_gok44
    s_cmp_lt_u32 s46, 32768
    s_cbranch_scc1 L_gpoll43
L_gok44:
    s_bitcmp1_b32 s4, 0
    s_cselect_b64 s[48:49], -1, 0
    v_cndmask_b32 v24, v28, v30, s[48:49]
    v_cndmask_b32 v26, v29, v31, s[48:49]
    v_and_b32 v24, s47, v24
    v_and_b32 v26, s47, v26
    s_nop 0
    v_add_f32_dpp v24, v24, v24 quad_perm:[1,0,3,2] row_mask:0xf bank_mask:0xf
    v_add_f32_dpp v26, v26, v26 quad_perm:[1,0,3,2] row_mask:0xf bank_mask:0xf
    s_nop 0
    v_add_f32_dpp v24, v24, v24 quad_perm:[2,3,0,1] row_mask:0xf bank_mask:0xf
    v_add_f32_dpp v26, v26, v26 quad_perm:[2,3,0,1] row_mask:0xf bank_mask:0xf
    s_nop 0
    v_add_f32_dpp v24, v24, v24 row_half_mirror row_mask:0xf bank_mask:0xf
L_pad9:
    s_cbranch_execz L_touch_ret3
    v_add_f32_dpp v26, v26, v26 row_half_mirror row_mask:0xf bank_mask:0xf
    s_nop 0
    v_add_f32_dpp v24, v24, v24 row_mirror row_mask:0xf bank_mask:0xf
    v_add_f32_dpp v26, v26, v26 row_mirror row_mask:0xf bank_mask:0xf
    v_mov_b32 v25, v24
    v_mov_b32 v27, v26
    s_nop 1
    v_permlane16_swap_b32 v24, v25
    v_permlane16_swap_b32 v26, v27
    v_add_f32 v24, v24, v25
    v_add_f32 v26, v26, v27
    v_cvt_pk_bf16_f32 v24, v24, v26
    v_and_b32 v25, 0xffff0000, v24
    v_lshlrev_b32 v24, 16, v24
    v_mul_f32 v24, v24, v12
    v_mul_f32 v25, v25, v13
    v_cvt_pk_bf16_f32 v24, v24, v25
    v_and_b32 v25, 0xffff0000, v24
    v_lshlrev_b32 v24, 16, v24
    v_add_f32 v24, v24, v10
    v_add_f32 v25, v25, v11
    v_cvt_pk_bf16_f32 v24, v24, v25
    s_mov_b64 exec, 1
    global_store_dword v3, v24, s[28:29]
    s_cmp_lg_u32 s2, 0
    s_cbranch_scc1 L_tail_end
    v_mov_b32 v25, s38
    buffer_store_dword v25, v2, s[92:95], 0 offen
L_tail_end:
    s_mov_b64 exec, -1
    s_endpgm
L_exit:
    s_endpgm
.section .rodata,"a"
.p2align 6
.amdhsa_kernel recurrent_scan__sliding_block_cached__mixer_token_mlp__decode_kernel
  .amdhsa_next_free_vgpr 128
  .amdhsa_next_free_sgpr 102
  .amdhsa_accum_offset 128
  .amdhsa_group_segment_fixed_size 0
  .amdhsa_kernarg_size 104
  .amdhsa_user_sgpr_count 2
  .amdhsa_user_sgpr_kernarg_segment_ptr 1
  .amdhsa_system_sgpr_workgroup_id_x 1
.end_amdhsa_kernel
```
